```python
import torch

def _softmax(x, axis=-1):
    return torch.softmax(x, dim=axis)
def _gelu(x):
    return torch.nn.functional.gelu(x, approximate="tanh")
def _silu(x):
    return torch.nn.functional.silu(x)
def _sigmoid(x):
    return torch.sigmoid(x)
def _layernorm(x, axis=-1, eps=1e-5):
    m = x.mean(dim=axis, keepdim=True)
    v = x.var(dim=axis, keepdim=True, unbiased=False)
    return (x - m) / torch.sqrt(v + eps)
def _scatter_add(tgt, idx, src, axis=0):
    return tgt.clone().index_add_(axis, idx, src)
def _segment_sum(src, seg, n):
    out = torch.zeros((n,) + src.shape[1:], dtype=src.dtype)
    return out.index_add_(0, seg, src)
def _pad(x, pw):
    flat = tuple(v for pair in reversed(pw) for v in pair)
    return torch.nn.functional.pad(x, flat)

kernel_name = 'standalone__paged_block_table_kv_radixattention__sampling'

def setup_inputs():

    _w = (lambda a: (lambda t: t.to(torch.bfloat16) if t.is_floating_point() else t)(torch.as_tensor(a)))
    B, H, Hkv, Dh = 16, 32, 8, 128
    Lk = 4096
    bs = 16
    nb = max(2, Lk // bs)
    P = max(1, nb // 2)
    n_phys = P + B * (nb - P)
    shared = torch.arange(P, dtype=torch.int64)
    priv = P + torch.arange(B * (nb - P), dtype=torch.int64).reshape(B, nb - P)
    bt = torch.cat([torch.tile(shared[None, :], (B, 1)), priv], dim=1)
    ctx = nb * bs - (torch.arange(1, B + 1, dtype=torch.int64) * 2654435761) % max(1, (nb * bs - P * bs) // 2)
    return {
        "q": _w((lambda *s: torch.randn(*s, dtype=torch.bfloat16) * 0.8)(B, H, Dh)),
        "k_cache": _w((lambda *s: torch.randn(*s, dtype=torch.bfloat16) * 0.8)(n_phys, bs, Hkv, Dh)),
        "v_cache": _w((lambda *s: torch.randn(*s, dtype=torch.bfloat16) * 0.05)(n_phys, bs, Hkv, Dh)),
        "block_table": _w(bt.to(torch.int64)),
        "ctx_lens": _w(torch.as_tensor(ctx).to(torch.int64)),
    }

def reference(q, k_cache, v_cache, block_table, ctx_lens):
    B, H, Dh = q.shape
    n_phys, bs, Hkv, _ = k_cache.shape
    nb = block_table.shape[1]
    Lk = nb * bs
    rep = H // Hkv
    k = k_cache[block_table].reshape(B, Lk, Hkv, Dh)
    v = v_cache[block_table].reshape(B, Lk, Hkv, Dh)
    k = (lambda x, n, axis: torch.repeat_interleave(x, n, dim=axis))(k, rep, axis=2)
    v = (lambda x, n, axis: torch.repeat_interleave(x, n, dim=axis))(v, rep, axis=2)
    scores = torch.einsum("bhd,bkhd->bhk", q, k) * (Dh ** -0.5)
    pos = torch.arange(Lk)
    valid = pos[None, :] < ctx_lens[:, None]
    scores = torch.where(valid[:, None, :], scores, -1e9)
    p = _softmax(scores, axis=-1)
    return torch.einsum("bhk,bkhd->bhd", p, v)
```

```asm
; @launch grid=(256,1,1) block=(256,1,1) lds=65536
.amdgcn_target "amdgcn-amd-amdhsa--gfx950"
.text
.globl standalone__paged_block_table_kv_radixattention__sampling_kernel
.p2align 8
.type standalone__paged_block_table_kv_radixattention__sampling_kernel,@function
standalone__paged_block_table_kv_radixattention__sampling_kernel:
    s_cmp_ge_u32 s2, 256
    s_cbranch_scc1 L_end
    s_load_dwordx16 s[4:19], s[0:1], 0
    v_lshrrev_b32 v116, 6, v0
    v_and_b32 v3, 15, v0
    v_bfe_u32 v2, v0, 4, 2
    v_readfirstlane_b32 s32, v116
    s_lshr_b32 s31, s2, 3
    s_lshr_b32 s82, s2, 1
    s_add_u32 s82, s82, s31
    s_and_b32 s83, s82, 2
    s_and_b32 s82, s82, 1
    s_and_b32 s84, s2, 1
    s_or_b32 s83, s83, s84
    s_lshl1_add_u32 s33, s83, s82
    v_xor_b32 v96, v3, v2
    v_lshlrev_b32 v97, 11, v2
    v_lshl_add_u32 v4, v96, 4, v97
    v_xor_b32 v5, 64, v4
    v_add_u32 v5, 7168, v5
    v_xor_b32 v6, 128, v4
    v_add_u32 v6, 14336, v6
    v_xor_b32 v7, 192, v4
    v_add_u32 v7, 21504, v7
    s_lshl_b32 s39, s32, 14
    s_mov_b32 s22, 71303168
    s_mov_b32 s23, 0x20000
    s_cmp_lt_u32 s31, 16
    s_cbranch_scc1 L_helper
    s_sub_u32 s82, s31, 15
    s_lshl_b32 s82, s82, 6
    s_add_u32 s82, s82, s32
    s_lshl_b32 s82, s82, 8
    s_add_u32 s82, s82, s33
    s_lshl_b32 s46, s82, 8
    s_add_u32 s47, s46, 0x8000
    s_mov_b32 s58, s47
    s_add_u32 s59, s47, 0x8000
    s_waitcnt lgkmcnt(0)
    s_mov_b32 s20, s6
    s_and_b32 s21, s7, 0xffff
    s_mov_b32 m0, s39
    s_mov_b32 s22, s58
    buffer_load_dwordx4 v4, s[20:23], s46 offen nt lds
    buffer_load_dwordx4 v5, s[20:23], s46 offen offset:1024 nt lds
    buffer_load_dwordx4 v6, s[20:23], s46 offen offset:2048 nt lds
    buffer_load_dwordx4 v7, s[20:23], s46 offen offset:3072 nt lds
    s_add_u32 m0, s39, 4096
    s_mov_b32 s22, s59
    buffer_load_dwordx4 v4, s[20:23], s47 offen nt lds
    buffer_load_dwordx4 v5, s[20:23], s47 offen offset:1024 nt lds
    buffer_load_dwordx4 v6, s[20:23], s47 offen offset:2048 nt lds
    buffer_load_dwordx4 v7, s[20:23], s47 offen offset:3072 nt lds
    v_and_b32 v1, 63, v0
    v_and_b32 v118, 3, v0
    v_lshlrev_b32 v90, 4, v2
    v_lshl_add_u32 v90, v118, 8, v90
    v_mov_b32 v86, 127
    s_mov_b32 s44, 0x000f000f
    s_mov_b32 s45, s44
    s_mov_b32 s37, 0
    s_mov_b32 s36, 1
    s_and_b32 s83, s2, 0x78
    s_or_b32 s83, s83, s33
    s_mul_i32 s28, s83, 0x01010101
    s_add_u32 s84, s32, 64
    v_lshl_add_u32 v116, v1, 2, s84
    v_mov_b32 v117, 0
    v_mov_b32 v119, s83
    v_med3_i32 v116, v116, 0, v86
    v_lshlrev_b32 v63, 5, v116
    v_lshl_add_u32 v63, v117, 18, v63
    v_lshl_add_u32 v63, v119, 29, v63
    v_lshrrev_b32 v119, 3, v119
    v_lshlrev_b32 v119, 10, v119
    v_lshl_add_u32 v119, v116, 3, v119
    s_and_b32 s82, s33, 3
    s_lshl_b32 s82, s82, 3
    s_lshr_b32 s53, 0x5e5f5a64, s82
    s_and_b32 s53, s53, 0xff
    s_mov_b32 s29, 0
    s_mov_b64 s[54:55], -1
L_go:
    global_load_dwordx2 v[64:65], v119, s[10:11]
    v_lshlrev_b32 v89, 1, v3
    v_and_b32 v89, 24, v89
    v_bfe_u32 v89, s28, v89, 8
    v_lshl_add_u32 v88, v89, 10, v90
    v_lshrrev_b32 v89, 1, v89
    v_and_b32 v89, 60, v89
    global_load_dword v62, v89, s[12:13]
    global_load_dwordx4 v[12:15], v88, s[4:5] offset:0
    global_load_dwordx4 v[16:19], v88, s[4:5] offset:64
    global_load_dwordx4 v[20:23], v88, s[4:5] offset:128
    global_load_dwordx4 v[24:27], v88, s[4:5] offset:192
    v_lshlrev_b32 v96, 1, v2
    v_xor_b32 v96, v3, v96
    v_lshl_add_u32 v8, v96, 4, v97
    v_xor_b32 v9, 128, v8
    v_add_u32 v11, 21504, v9
    v_add_u32 v9, 7168, v9
    v_add_u32 v10, 14336, v8
    s_mov_b32 s24, s8
    s_and_b32 s25, s9, 0xffff
    s_mov_b32 s27, 0x20000
    s_add_u32 m0, s39, 8192
    s_mov_b32 s26, s58
    buffer_load_dwordx4 v8, s[24:27], s46 offen nt lds
    buffer_load_dwordx4 v9, s[24:27], s46 offen offset:1024 nt lds
    buffer_load_dwordx4 v10, s[24:27], s46 offen offset:2048 nt lds
    buffer_load_dwordx4 v11, s[24:27], s46 offen offset:3072 nt lds
    s_add_u32 m0, s39, 12288
    s_mov_b32 s26, s59
    buffer_load_dwordx4 v8, s[24:27], s47 offen nt lds
    buffer_load_dwordx4 v9, s[24:27], s47 offen offset:1024 nt lds
    buffer_load_dwordx4 v10, s[24:27], s47 offen offset:2048 nt lds
    buffer_load_dwordx4 v11, s[24:27], s47 offen offset:3072 nt lds
L_init:
    s_mov_b32 s40, 0x3e0293ee
    v_mov_b32 v28, 0
    v_mov_b32 v29, 0
    v_mov_b32 v30, 0
    v_mov_b32 v31, 0
    v_mov_b32 v32, 0
    v_mov_b32 v33, 0
    v_mov_b32 v34, 0
    v_mov_b32 v35, 0
    v_mov_b32 v36, 0
    v_mov_b32 v37, 0
    v_mov_b32 v38, 0
    v_mov_b32 v39, 0
    v_mov_b32 v40, 0
    v_mov_b32 v41, 0
    v_mov_b32 v42, 0
    v_mov_b32 v43, 0
    v_mov_b32 v44, 0
    v_mov_b32 v45, 0
    v_mov_b32 v46, 0
    v_mov_b32 v47, 0
    v_mov_b32 v48, 0
    v_mov_b32 v49, 0
    v_mov_b32 v50, 0
    v_mov_b32 v51, 0
    v_mov_b32 v52, 0
    v_mov_b32 v53, 0
    v_mov_b32 v54, 0
    v_mov_b32 v55, 0
    v_mov_b32 v56, 0
    v_mov_b32 v57, 0
    v_mov_b32 v58, 0
    v_mov_b32 v59, 0
    v_mov_b32 v60, 0xf149f2ca
    v_mov_b32 v61, 0
    v_mov_b32 v66, 0xd028965f
    v_mov_b32 v67, 0xff61b1e6
    s_cmp_eq_u32 s36, 2
    s_cselect_b32 s82, 0, s39
    v_xor_b32 v116, v3, v2
    v_lshl_add_u32 v117, v3, 8, s82
    v_lshl_add_u32 v120, v116, 4, v117
    v_xor_b32 v121, 64, v120
    v_xor_b32 v122, 128, v120
    v_xor_b32 v123, 192, v120
    v_lshrrev_b32 v116, 2, v1
    v_lshl_add_u32 v117, v116, 8, s82
    v_and_b32 v116, 7, v116
    v_lshl_add_u32 v117, v116, 5, v117
    v_and_b32 v116, 3, v1
    v_lshl_add_u32 v124, v116, 3, v117
    v_xor_b32 v125, 32, v124
    v_xor_b32 v126, 64, v124
    v_xor_b32 v127, 96, v124
    v_xor_b32 v128, 128, v124
    v_xor_b32 v129, 160, v124
    v_xor_b32 v130, 192, v124
    v_xor_b32 v131, 224, v124
    s_cmp_eq_u32 s36, 1
    s_cselect_b32 s82, 3, 15
    v_lshrrev_b32 v231, 4, v0
    v_and_b32 v231, s82, v231
    v_lshlrev_b32 v116, 1, v231
    v_and_b32 v116, 24, v116
    v_bfe_u32 v116, s28, v116, 8
    v_and_b32 v225, 3, v231
    v_lshl_add_u32 v116, v116, 2, v225
    s_lshl_b32 s85, s29, 9
    v_lshl_add_u32 v224, v116, 12, s85
    s_lshl_b32 s85, s29, 4
    s_add_u32 s85, s85, 2097152
    v_lshl_add_u32 v225, v116, 7, s85
    v_lshl_add_u32 v224, v3, 4, v224
    v_mul_u32_u24 v227, 528, v3
    v_lshl_add_u32 v227, v2, 4, v227
    v_add_u32 v227, s39, v227
    v_lshl_add_u32 v228, v3, 3, s39
    v_lshlrev_b32 v229, 3, v231
    v_mul_u32_u24 v230, 528, v231
    v_lshl_add_u32 v230, v3, 4, v230
    s_and_b32 s85, s28, 0xff
    s_lshl_b32 s85, s85, 10
    v_lshl_add_u32 v226, v2, 8, s85
    v_lshl_add_u32 v226, v3, 3, v226
    s_add_u32 s62, s32, 1
    s_cmp_lt_u32 s32, 2
    s_cselect_b32 s62, s62, 0
    s_mul_i32 s62, s62, s36
    v_lshlrev_b32 v223, 4, v1
    s_mov_b32 s63, 0
    s_cmp_eq_u32 s36, 2
    s_waitcnt vmcnt(8)
    v_mov_b32 v117, 0x1000
    v_cmp_lt_i32 vcc, 0, v62
    v_lshlrev_b32 v116, 2, v2
    v_med3_i32 v62, v62, 0, v117
    v_cndmask_b32 v132, v117, v62, vcc
    v_sub_u32 v62, v62, v116
    s_cbranch_scc1 L_sh_verify
    s_mov_b64 s[66:67], s[46:47]
    s_mov_b64 s[68:69], s[58:59]
    v_readlane_b32 s84, v63, s37
    v_readlane_b32 s82, v64, s37
    v_readlane_b32 s83, v65, s37
    s_bfe_u32 s85, s84, 0x40010
    s_lshr_b32 s86, s84, 29
    v_readlane_b32 s87, v132, s85
    s_lshl_b32 s86, s86, 8
    s_lshl_b32 s82, s82, 15
    s_lshl_b32 s83, s83, 15
    s_or_b32 s46, s82, s86
    s_or_b32 s47, s83, s86
    s_and_b32 s48, s84, 0xffff
    s_lshl_b64 s[50:51], s[54:55], s85
    s_add_u32 s37, s37, 1
    s_sub_i32 s87, s87, s48
    s_max_i32 s87, s87, 0
    s_min_u32 s82, s87, 16
    s_min_u32 s83, s87, 32
    s_sub_u32 s83, s83, s82
    s_lshl_b32 s82, s82, 11
    s_lshl_b32 s83, s83, 11
    s_add_u32 s82, s82, s46
    s_add_u32 s83, s83, s47
    s_min_u32 s58, s82, 71303168
    s_min_u32 s59, s83, 71303168
    s_xor_b64 s[66:67], s[66:67], s[46:47]
    s_xor_b64 s[68:69], s[68:69], s[58:59]
    s_or_b64 s[66:67], s[66:67], s[68:69]
    s_cbranch_scc1 L_respec
L_specok:
    s_cmp_eq_u32 s36, 1
    s_cbranch_scc0 L_cnt
    v_readfirstlane_b32 s83, v132
    s_add_u32 s83, s83, 31
    s_lshr_b32 s83, s83, 5
    s_min_u32 s83, s83, s53
    s_sub_i32 s83, s83, s32
    s_sub_i32 s83, s83, 61
    s_ashr_i32 s83, s83, 2
    s_max_i32 s38, s83, 1
L_cnt:
L_loop:
    s_waitcnt vmcnt(8) lgkmcnt(0)
    ds_read_b128 v[80:83], v120
    ds_read_b128 v[84:87], v120 offset:4096
    ds_read_b128 v[88:91], v121
    ds_read_b128 v[92:95], v121 offset:4096
    ds_read_b128 v[96:99], v122
    ds_read_b128 v[100:103], v122 offset:4096
    ds_read_b128 v[104:107], v123
    ds_read_b128 v[108:111], v123 offset:4096
    v_subrev_u32 v112, s48, v62
    v_cndmask_b32 v112, 0, v112, s[50:51]
    v_cndmask_b32 v113, v67, v66, s[50:51]
    v_cmp_gt_i32 s[56:57], 20, v112
    v_readlane_b32 s84, v63, s37
    v_readlane_b32 s82, v64, s37
    v_readlane_b32 s83, v65, s37
    s_bfe_u32 s85, s84, 0x40010
    s_lshr_b32 s86, s84, 29
    v_readlane_b32 s87, v132, s85
    s_lshl_b32 s86, s86, 8
    s_lshl_b32 s82, s82, 15
    s_lshl_b32 s83, s83, 15
    s_or_b32 s46, s82, s86
    s_or_b32 s47, s83, s86
    s_and_b32 s48, s84, 0xffff
    s_lshl_b64 s[50:51], s[54:55], s85
    s_add_u32 s37, s37, 1
    s_sub_i32 s87, s87, s48
    s_max_i32 s87, s87, 0
    s_min_u32 s82, s87, 16
    s_min_u32 s83, s87, 32
    s_sub_u32 s83, s83, s82
    s_lshl_b32 s82, s82, 11
    s_lshl_b32 s83, s83, 11
    s_add_u32 s82, s82, s46
    s_add_u32 s83, s83, s47
    s_min_u32 s58, s82, 71303168
    s_min_u32 s59, s83, 71303168
    s_waitcnt lgkmcnt(6)
    v_mfma_f32_16x16x32_bf16 v[68:71], v[80:83], v[12:15], 0
    v_mfma_f32_16x16x32_bf16 v[72:75], v[84:87], v[12:15], 0
    s_waitcnt lgkmcnt(4)
    v_mfma_f32_16x16x32_bf16 v[68:71], v[88:91], v[16:19], v[68:71]
    v_mfma_f32_16x16x32_bf16 v[72:75], v[92:95], v[16:19], v[72:75]
    s_waitcnt lgkmcnt(2)
    v_mfma_f32_16x16x32_bf16 v[68:71], v[96:99], v[20:23], v[68:71]
    v_mfma_f32_16x16x32_bf16 v[72:75], v[100:103], v[20:23], v[72:75]
    s_waitcnt lgkmcnt(0)
    v_mfma_f32_16x16x32_bf16 v[68:71], v[104:107], v[24:27], v[68:71]
    v_mfma_f32_16x16x32_bf16 v[72:75], v[108:111], v[24:27], v[72:75]
    s_cmp_eq_u32 s38, 1
    s_cbranch_scc1 L_noK
    s_mov_b32 m0, s39
    s_mov_b32 s22, s58
    buffer_load_dwordx4 v4, s[20:23], s46 offen nt lds
    buffer_load_dwordx4 v5, s[20:23], s46 offen offset:1024 nt lds
    buffer_load_dwordx4 v6, s[20:23], s46 offen offset:2048 nt lds
    buffer_load_dwordx4 v7, s[20:23], s46 offen offset:3072 nt lds
    s_add_u32 m0, s39, 4096
    s_mov_b32 s22, s59
    buffer_load_dwordx4 v4, s[20:23], s47 offen nt lds
    buffer_load_dwordx4 v5, s[20:23], s47 offen offset:1024 nt lds
    buffer_load_dwordx4 v6, s[20:23], s47 offen offset:2048 nt lds
    buffer_load_dwordx4 v7, s[20:23], s47 offen offset:3072 nt lds
    s_branch L_sm
L_noK:
    s_cmp_lg_u32 s62, 0
    s_cbranch_scc1 L_early
    s_nop 6
L_sm:
    s_cmp_eq_u64 s[56:57], 0
    s_cbranch_scc1 L_1
    v_cmp_lt_i32 s[66:67], 0, v112
    v_cmp_lt_i32 s[68:69], 1, v112
    v_cmp_lt_i32 s[70:71], 2, v112
    v_cmp_lt_i32 s[72:73], 3, v112
    v_cmp_lt_i32 s[74:75], 16, v112
    v_cmp_lt_i32 s[76:77], 17, v112
    v_cmp_lt_i32 s[78:79], 18, v112
    v_cmp_lt_i32 s[80:81], 19, v112
    v_cndmask_b32 v68, v113, v68, s[66:67]
    v_cndmask_b32 v69, v113, v69, s[68:69]
    v_cndmask_b32 v70, v113, v70, s[70:71]
    v_cndmask_b32 v71, v113, v71, s[72:73]
    v_cndmask_b32 v72, v113, v72, s[74:75]
    v_cndmask_b32 v73, v113, v73, s[76:77]
    v_cndmask_b32 v74, v113, v74, s[78:79]
    v_cndmask_b32 v75, v113, v75, s[80:81]
L_1:
    v_max3_f32 v114, v68, v69, v70
    v_max3_f32 v116, v71, v72, v73
    v_max3_f32 v114, v114, v74, v75
    v_max3_f32 v114, v114, v116, v60
    v_mov_b32 v116, v114
    s_nop 1
    v_permlane32_swap_b32 v114, v116
    v_max_f32 v114, v114, v116
    v_mov_b32 v116, v114
    s_nop 1
    v_permlane16_swap_b32 v114, v116
    v_max_f32 v114, v114, v116
    v_mul_f32 v117, s40, v114
    v_sub_f32 v115, v60, v114
    v_cmp_lt_f32 vcc, v60, v114
    v_fma_f32 v68, v68, s40, -v117
    v_fma_f32 v69, v69, s40, -v117
    v_fma_f32 v70, v70, s40, -v117
    v_fma_f32 v71, v71, s40, -v117
    v_fma_f32 v72, v72, s40, -v117
    v_fma_f32 v73, v73, s40, -v117
    v_fma_f32 v74, v74, s40, -v117
    v_fma_f32 v75, v75, s40, -v117
    v_mul_f32 v115, s40, v115
    v_exp_f32 v68, v68
    v_exp_f32 v69, v69
    v_exp_f32 v70, v70
    v_exp_f32 v71, v71
    v_exp_f32 v72, v72
    v_exp_f32 v73, v73
    v_exp_f32 v74, v74
    v_exp_f32 v75, v75
    v_exp_f32 v115, v115
    v_mov_b32 v60, v114
    v_cvt_pk_bf16_f32 v76, v68, v69
    v_cvt_pk_bf16_f32 v77, v70, v71
    v_cvt_pk_bf16_f32 v78, v72, v73
    v_cvt_pk_bf16_f32 v79, v74, v75
    v_pk_add_f32 v[68:69], v[68:69], v[70:71]
    v_pk_add_f32 v[72:73], v[72:73], v[74:75]
    v_pk_add_f32 v[68:69], v[68:69], v[72:73]
    v_fma_f32 v61, v61, v115, v68
    v_add_f32 v61, v61, v69
    s_cbranch_vccz L_2
    v_pk_mul_f32 v[28:29], v[28:29], v[114:115] op_sel:[0,1] op_sel_hi:[1,1]
    v_pk_mul_f32 v[30:31], v[30:31], v[114:115] op_sel:[0,1] op_sel_hi:[1,1]
    v_pk_mul_f32 v[32:33], v[32:33], v[114:115] op_sel:[0,1] op_sel_hi:[1,1]
    v_pk_mul_f32 v[34:35], v[34:35], v[114:115] op_sel:[0,1] op_sel_hi:[1,1]
    v_pk_mul_f32 v[36:37], v[36:37], v[114:115] op_sel:[0,1] op_sel_hi:[1,1]
    v_pk_mul_f32 v[38:39], v[38:39], v[114:115] op_sel:[0,1] op_sel_hi:[1,1]
    v_pk_mul_f32 v[40:41], v[40:41], v[114:115] op_sel:[0,1] op_sel_hi:[1,1]
    v_pk_mul_f32 v[42:43], v[42:43], v[114:115] op_sel:[0,1] op_sel_hi:[1,1]
    v_pk_mul_f32 v[44:45], v[44:45], v[114:115] op_sel:[0,1] op_sel_hi:[1,1]
    v_pk_mul_f32 v[46:47], v[46:47], v[114:115] op_sel:[0,1] op_sel_hi:[1,1]
    v_pk_mul_f32 v[48:49], v[48:49], v[114:115] op_sel:[0,1] op_sel_hi:[1,1]
    v_pk_mul_f32 v[50:51], v[50:51], v[114:115] op_sel:[0,1] op_sel_hi:[1,1]
    v_pk_mul_f32 v[52:53], v[52:53], v[114:115] op_sel:[0,1] op_sel_hi:[1,1]
    v_pk_mul_f32 v[54:55], v[54:55], v[114:115] op_sel:[0,1] op_sel_hi:[1,1]
    v_pk_mul_f32 v[56:57], v[56:57], v[114:115] op_sel:[0,1] op_sel_hi:[1,1]
    v_pk_mul_f32 v[58:59], v[58:59], v[114:115] op_sel:[0,1] op_sel_hi:[1,1]
L_2:
    s_cmp_eq_u32 s38, 1
    s_cbranch_scc1 L_last
    s_waitcnt vmcnt(8)
    s_branch L_vok
L_last:
    v_mov_b32 v116, v61
    s_nop 1
    v_permlane32_swap_b32 v61, v116
    v_add_f32 v61, v61, v116
    v_mov_b32 v116, v61
    s_nop 1
    v_permlane16_swap_b32 v61, v116
    v_add_f32 v61, v61, v116
    s_cmp_eq_u32 s62, 2
    s_waitcnt vmcnt(12)
    s_cbranch_scc1 L_vok
    s_cmp_eq_u32 s62, 1
    s_waitcnt vmcnt(9)
    s_cbranch_scc1 L_vok
    s_waitcnt vmcnt(0)
L_vok:
    ds_read_b64_tr_b16 v[80:81], v124 offset:8192
    ds_read_b64_tr_b16 v[82:83], v124 offset:12288
    ds_read_b64_tr_b16 v[84:85], v125 offset:8192
    ds_read_b64_tr_b16 v[86:87], v125 offset:12288
    ds_read_b64_tr_b16 v[88:89], v126 offset:8192
    ds_read_b64_tr_b16 v[90:91], v126 offset:12288
    ds_read_b64_tr_b16 v[92:93], v127 offset:8192
    ds_read_b64_tr_b16 v[94:95], v127 offset:12288
    ds_read_b64_tr_b16 v[96:97], v128 offset:8192
    ds_read_b64_tr_b16 v[98:99], v128 offset:12288
    ds_read_b64_tr_b16 v[100:101], v129 offset:8192
    ds_read_b64_tr_b16 v[102:103], v129 offset:12288
    ds_read_b64_tr_b16 v[104:105], v130 offset:8192
    ds_read_b64_tr_b16 v[106:107], v130 offset:12288
    ds_read_b64_tr_b16 v[108:109], v131 offset:8192
    ds_read_b64_tr_b16 v[110:111], v131 offset:12288
    s_waitcnt lgkmcnt(14)
    v_mfma_f32_16x16x32_bf16 v[28:31], v[80:83], v[76:79], v[28:31]
    s_waitcnt lgkmcnt(12)
    v_mfma_f32_16x16x32_bf16 v[32:35], v[84:87], v[76:79], v[32:35]
    s_waitcnt lgkmcnt(10)
    v_mfma_f32_16x16x32_bf16 v[36:39], v[88:91], v[76:79], v[36:39]
    s_waitcnt lgkmcnt(8)
    v_mfma_f32_16x16x32_bf16 v[40:43], v[92:95], v[76:79], v[40:43]
    s_waitcnt lgkmcnt(6)
    v_mfma_f32_16x16x32_bf16 v[44:47], v[96:99], v[76:79], v[44:47]
    s_waitcnt lgkmcnt(4)
    v_mfma_f32_16x16x32_bf16 v[48:51], v[100:103], v[76:79], v[48:51]
    s_waitcnt lgkmcnt(2)
    v_mfma_f32_16x16x32_bf16 v[52:55], v[104:107], v[76:79], v[52:55]
    s_waitcnt lgkmcnt(0)
    v_mfma_f32_16x16x32_bf16 v[56:59], v[108:111], v[76:79], v[56:59]
    s_cmp_eq_u32 s38, 1
    s_cbranch_scc1 L_epi
    s_add_u32 m0, s39, 8192
    s_mov_b32 s26, s58
    buffer_load_dwordx4 v8, s[24:27], s46 offen nt lds
    buffer_load_dwordx4 v9, s[24:27], s46 offen offset:1024 nt lds
    buffer_load_dwordx4 v10, s[24:27], s46 offen offset:2048 nt lds
    buffer_load_dwordx4 v11, s[24:27], s46 offen offset:3072 nt lds
    s_add_u32 m0, s39, 12288
    s_mov_b32 s26, s59
    buffer_load_dwordx4 v8, s[24:27], s47 offen nt lds
    buffer_load_dwordx4 v9, s[24:27], s47 offen offset:1024 nt lds
    buffer_load_dwordx4 v10, s[24:27], s47 offen offset:2048 nt lds
    buffer_load_dwordx4 v11, s[24:27], s47 offen offset:3072 nt lds
    s_cmp_eq_u32 s37, 4
    s_cbranch_scc0 L_hook_done
    s_load_dword s63, s[16:17], 0x40
L_hook_done:
    s_sub_u32 s38, s38, 1
    s_branch L_loop
L_epi:
    s_cmp_eq_u32 s36, 1
    s_cselect_b64 exec, s[44:45], -1
    ds_write_b64 v228, v[60:61] offset:8448
    s_nop 1
    ds_write_b128 v227, v[28:31] offset:0
    ds_write_b128 v227, v[32:35] offset:64
    ds_write_b128 v227, v[36:39] offset:128
    ds_write_b128 v227, v[40:43] offset:192
    ds_write_b128 v227, v[44:47] offset:256
    ds_write_b128 v227, v[48:51] offset:320
    ds_write_b128 v227, v[52:55] offset:384
    ds_write_b128 v227, v[56:59] offset:448
    s_mov_b64 exec, -1
    s_cbranch_scc1 L_fin
    s_mov_b32 s87, 0
    v_mov_b32 v116, 64
L_3:
    s_cmp_lg_u32 s63, 0
    s_cbranch_scc1 L_4
    global_load_dword v133, v116, s[16:17] sc1
    s_sleep 8
    s_add_u32 s87, s87, 1
    s_waitcnt vmcnt(0)
    v_readfirstlane_b32 s63, v133
    s_cmp_lt_u32 s87, 0x40000
    s_cbranch_scc1 L_3
L_4:
    v_mov_b32 v133, s63
    s_mov_b32 s74, 0x07060500
    s_mov_b32 s75, 0x07060501
    s_mov_b32 s76, 0x07060502
    s_mov_b32 s77, 0x07060503
    s_waitcnt lgkmcnt(0)
    s_barrier
    ds_read_b64 v[68:69], v229 offset:8448
    ds_read_b64 v[70:71], v229 offset:24832
    ds_read_b64 v[72:73], v229 offset:41216
    ds_read_b64 v[74:75], v229 offset:57600
    ds_read_b128 v[80:83], v230 offset:0
    ds_read_b128 v[84:87], v230 offset:256
    ds_read_b128 v[88:91], v230 offset:16384
    ds_read_b128 v[92:95], v230 offset:16640
    ds_read_b128 v[96:99], v230 offset:32768
    ds_read_b128 v[100:103], v230 offset:33024
    ds_read_b128 v[104:107], v230 offset:49152
    ds_read_b128 v[108:111], v230 offset:49408
    s_waitcnt lgkmcnt(8)
    v_max3_f32 v114, v68, v70, v72
    v_max_f32 v114, v114, v74
    v_sub_f32 v20, v68, v114
    v_sub_f32 v21, v70, v114
    v_sub_f32 v22, v72, v114
    v_sub_f32 v23, v74, v114
    v_mul_f32 v20, s40, v20
    v_mul_f32 v21, s40, v21
    v_mul_f32 v22, s40, v22
    v_mul_f32 v23, s40, v23
    v_exp_f32 v20, v20
    v_exp_f32 v21, v21
    v_exp_f32 v22, v22
    v_exp_f32 v23, v23
    s_nop 0
    v_mul_f32 v115, v20, v69
    v_fmac_f32 v115, v21, v71
    v_fmac_f32 v115, v22, v73
    v_fmac_f32 v115, v23, v75
    s_waitcnt lgkmcnt(6)
    v_pk_mul_f32 v[12:13], v[80:81], v[20:21] op_sel:[0,0] op_sel_hi:[1,0]
    v_pk_mul_f32 v[14:15], v[82:83], v[20:21] op_sel:[0,0] op_sel_hi:[1,0]
    v_pk_mul_f32 v[16:17], v[84:85], v[20:21] op_sel:[0,0] op_sel_hi:[1,0]
    v_pk_mul_f32 v[18:19], v[86:87], v[20:21] op_sel:[0,0] op_sel_hi:[1,0]
    s_waitcnt lgkmcnt(4)
    v_pk_fma_f32 v[12:13], v[88:89], v[20:21], v[12:13] op_sel:[0,1,0] op_sel_hi:[1,1,1]
    v_pk_fma_f32 v[14:15], v[90:91], v[20:21], v[14:15] op_sel:[0,1,0] op_sel_hi:[1,1,1]
    v_pk_fma_f32 v[16:17], v[92:93], v[20:21], v[16:17] op_sel:[0,1,0] op_sel_hi:[1,1,1]
    v_pk_fma_f32 v[18:19], v[94:95], v[20:21], v[18:19] op_sel:[0,1,0] op_sel_hi:[1,1,1]
    s_waitcnt lgkmcnt(2)
    v_pk_fma_f32 v[12:13], v[96:97], v[22:23], v[12:13] op_sel:[0,0,0] op_sel_hi:[1,0,1]
    v_pk_fma_f32 v[14:15], v[98:99], v[22:23], v[14:15] op_sel:[0,0,0] op_sel_hi:[1,0,1]
    v_pk_fma_f32 v[16:17], v[100:101], v[22:23], v[16:17] op_sel:[0,0,0] op_sel_hi:[1,0,1]
    v_pk_fma_f32 v[18:19], v[102:103], v[22:23], v[18:19] op_sel:[0,0,0] op_sel_hi:[1,0,1]
    s_waitcnt lgkmcnt(0)
    v_pk_fma_f32 v[12:13], v[104:105], v[22:23], v[12:13] op_sel:[0,1,0] op_sel_hi:[1,1,1]
    v_pk_fma_f32 v[14:15], v[106:107], v[22:23], v[14:15] op_sel:[0,1,0] op_sel_hi:[1,1,1]
    v_pk_fma_f32 v[16:17], v[108:109], v[22:23], v[16:17] op_sel:[0,1,0] op_sel_hi:[1,1,1]
    v_pk_fma_f32 v[18:19], v[110:111], v[22:23], v[18:19] op_sel:[0,1,0] op_sel_hi:[1,1,1]
    v_perm_b32 v12, v12, v133, s74
    v_perm_b32 v13, v13, v133, s75
    v_perm_b32 v14, v14, v133, s76
    v_perm_b32 v15, v15, v133, s77
    v_perm_b32 v16, v16, v133, s74
    v_perm_b32 v17, v17, v133, s75
    v_perm_b32 v18, v18, v133, s76
    v_perm_b32 v19, v19, v133, s77
    v_perm_b32 v115, v115, v133, s75
    v_xor_b32 v116, v114, v133
    v_mov_b32 v117, v133
    global_store_dwordx4 v224, v[12:15], s[18:19] sc1
    global_store_dwordx4 v224, v[16:19], s[18:19] offset:256 sc1
    v_cmp_eq_u32 vcc, 0, v3
    s_and_saveexec_b64 s[66:67], vcc
    global_store_dwordx4 v225, v[114:117], s[18:19] sc1
    s_mov_b64 exec, s[66:67]
    s_branch L_done
L_fin:
    s_cmp_lg_u32 s62, 0
    s_cbranch_scc1 L_merge
    s_waitcnt lgkmcnt(0)
    s_barrier
    s_branch L_done
L_merge:
    s_mov_b32 s87, 0
    v_mov_b32 v116, 64
L_5:
    s_cmp_lg_u32 s63, 0
    s_cbranch_scc1 L_6
    global_load_dword v133, v116, s[16:17] sc1
    s_sleep 8
    s_add_u32 s87, s87, 1
    s_waitcnt vmcnt(0)
    v_readfirstlane_b32 s63, v133
    s_cmp_lt_u32 s87, 0x40000
    s_cbranch_scc1 L_5
L_6:
    s_bfe_u32 s74, s63, 0x80000
    s_bfe_u32 s75, s63, 0x80008
    s_bfe_u32 s76, s63, 0x80010
    s_bfe_u32 s77, s63, 0x80018
    s_mov_b32 s87, 0
    s_cmp_eq_u32 s62, 1
    s_cbranch_scc1 L_chkB
    s_branch L_chkA
L_reloadA:
    global_load_dwordx4 v[140:143], v225, s[18:19] offset:0 sc1
    global_load_dwordx4 v[168:171], v224, s[18:19] offset:0 sc1
    global_load_dwordx4 v[172:175], v224, s[18:19] offset:256 sc1
    global_load_dwordx4 v[144:147], v225, s[18:19] offset:16 sc1
    global_load_dwordx4 v[176:179], v224, s[18:19] offset:512 sc1
    global_load_dwordx4 v[180:183], v224, s[18:19] offset:768 sc1
    global_load_dwordx4 v[148:151], v225, s[18:19] offset:32 sc1
    global_load_dwordx4 v[184:187], v224, s[18:19] offset:1024 sc1
    global_load_dwordx4 v[188:191], v224, s[18:19] offset:1280 sc1
    global_load_dwordx4 v[152:155], v225, s[18:19] offset:48 sc1
    global_load_dwordx4 v[192:195], v224, s[18:19] offset:1536 sc1
    global_load_dwordx4 v[196:199], v224, s[18:19] offset:1792 sc1
L_chkA:
    s_waitcnt vmcnt(0)
    v_xor_b32 v141, s75, v141
    v_xor_b32 v142, v140, v142
    v_xor_b32 v168, s74, v168
    v_xor_b32 v169, s75, v169
    v_xor_b32 v170, s76, v170
    v_xor_b32 v171, s77, v171
    v_xor_b32 v172, s74, v172
    v_xor_b32 v173, s75, v173
    v_xor_b32 v174, s76, v174
    v_xor_b32 v175, s77, v175
    v_xor_b32 v145, s75, v145
    v_xor_b32 v146, v144, v146
    v_xor_b32 v176, s74, v176
    v_xor_b32 v177, s75, v177
    v_xor_b32 v178, s76, v178
    v_xor_b32 v179, s77, v179
    v_xor_b32 v180, s74, v180
    v_xor_b32 v181, s75, v181
    v_xor_b32 v182, s76, v182
    v_xor_b32 v183, s77, v183
    v_xor_b32 v149, s75, v149
    v_xor_b32 v150, v148, v150
    v_xor_b32 v184, s74, v184
    v_xor_b32 v185, s75, v185
    v_xor_b32 v186, s76, v186
    v_xor_b32 v187, s77, v187
    v_xor_b32 v188, s74, v188
    v_xor_b32 v189, s75, v189
    v_xor_b32 v190, s76, v190
    v_xor_b32 v191, s77, v191
    v_xor_b32 v153, s75, v153
    v_xor_b32 v154, v152, v154
    v_xor_b32 v192, s74, v192
    v_xor_b32 v193, s75, v193
    v_xor_b32 v194, s76, v194
    v_xor_b32 v195, s77, v195
    v_xor_b32 v196, s74, v196
    v_xor_b32 v197, s75, v197
    v_xor_b32 v198, s76, v198
    v_xor_b32 v199, s77, v199
    v_msad_u8 v117, v142, s63, 0
    v_msad_u8 v117, v146, s63, v117
    v_msad_u8 v117, v150, s63, v117
    v_msad_u8 v117, v154, s63, v117
    v_or3_b32 v116, v141, v168, v169
    v_or3_b32 v116, v116, v170, v171
    v_or3_b32 v116, v116, v172, v173
    v_or3_b32 v116, v116, v174, v175
    v_or3_b32 v116, v116, v145, v176
    v_or3_b32 v116, v116, v177, v178
    v_or3_b32 v116, v116, v179, v180
    v_or3_b32 v116, v116, v181, v182
    v_or3_b32 v116, v116, v183, v149
    v_or3_b32 v116, v116, v184, v185
    v_or3_b32 v116, v116, v186, v187
    v_or3_b32 v116, v116, v188, v189
    v_or3_b32 v116, v116, v190, v191
    v_or3_b32 v116, v116, v153, v192
    v_or3_b32 v116, v116, v193, v194
    v_or3_b32 v116, v116, v195, v196
    v_or3_b32 v116, v116, v197, v198
    v_or_b32 v116, v116, v199
    v_and_b32 v116, 0xff, v116
    v_or_b32 v116, v116, v117
    v_cmp_ne_u32 vcc, 0, v116
    s_add_u32 s87, s87, 1
    s_cbranch_vccz L_readyA
    s_sleep 1
    s_cmp_lt_u32 s87, 0x40000
    s_cbranch_scc1 L_reloadA
L_readyA:
    v_max3_f32 v114, v140, v144, v148
    v_max_f32 v114, v114, v152
    v_sub_f32 v20, v140, v114
    v_sub_f32 v21, v144, v114
    v_sub_f32 v22, v148, v114
    v_sub_f32 v23, v152, v114
    v_mul_f32 v20, s40, v20
    v_mul_f32 v21, s40, v21
    v_mul_f32 v22, s40, v22
    v_mul_f32 v23, s40, v23
    v_exp_f32 v20, v20
    v_exp_f32 v21, v21
    v_exp_f32 v22, v22
    v_exp_f32 v23, v23
    v_mov_b32 v140, v114
    v_mul_f32 v141, v20, v141
    v_pk_mul_f32 v[168:169], v[168:169], v[20:21] op_sel:[0,0] op_sel_hi:[1,0]
    v_pk_mul_f32 v[170:171], v[170:171], v[20:21] op_sel:[0,0] op_sel_hi:[1,0]
    v_pk_mul_f32 v[172:173], v[172:173], v[20:21] op_sel:[0,0] op_sel_hi:[1,0]
    v_pk_mul_f32 v[174:175], v[174:175], v[20:21] op_sel:[0,0] op_sel_hi:[1,0]
    v_fmac_f32 v141, v21, v145
    v_pk_fma_f32 v[168:169], v[176:177], v[20:21], v[168:169] op_sel:[0,1,0] op_sel_hi:[1,1,1]
    v_pk_fma_f32 v[170:171], v[178:179], v[20:21], v[170:171] op_sel:[0,1,0] op_sel_hi:[1,1,1]
    v_pk_fma_f32 v[172:173], v[180:181], v[20:21], v[172:173] op_sel:[0,1,0] op_sel_hi:[1,1,1]
    v_pk_fma_f32 v[174:175], v[182:183], v[20:21], v[174:175] op_sel:[0,1,0] op_sel_hi:[1,1,1]
    v_fmac_f32 v141, v22, v149
    v_pk_fma_f32 v[168:169], v[184:185], v[22:23], v[168:169] op_sel:[0,0,0] op_sel_hi:[1,0,1]
    v_pk_fma_f32 v[170:171], v[186:187], v[22:23], v[170:171] op_sel:[0,0,0] op_sel_hi:[1,0,1]
    v_pk_fma_f32 v[172:173], v[188:189], v[22:23], v[172:173] op_sel:[0,0,0] op_sel_hi:[1,0,1]
    v_pk_fma_f32 v[174:175], v[190:191], v[22:23], v[174:175] op_sel:[0,0,0] op_sel_hi:[1,0,1]
    v_fmac_f32 v141, v23, v153
    v_pk_fma_f32 v[168:169], v[192:193], v[22:23], v[168:169] op_sel:[0,1,0] op_sel_hi:[1,1,1]
    v_pk_fma_f32 v[170:171], v[194:195], v[22:23], v[170:171] op_sel:[0,1,0] op_sel_hi:[1,1,1]
    v_pk_fma_f32 v[172:173], v[196:197], v[22:23], v[172:173] op_sel:[0,1,0] op_sel_hi:[1,1,1]
    v_pk_fma_f32 v[174:175], v[198:199], v[22:23], v[174:175] op_sel:[0,1,0] op_sel_hi:[1,1,1]
    ds_write_b64 v223, v[140:141] offset:30720
    ds_write_b128 v223, v[168:171] offset:28672
    ds_write_b128 v223, v[172:175] offset:29696
    s_waitcnt lgkmcnt(0)
    s_barrier
    s_branch L_done
L_reloadB:
    global_load_dwordx4 v[140:143], v225, s[18:19] offset:64 sc1
    global_load_dwordx4 v[168:171], v224, s[18:19] offset:2048 sc1
    global_load_dwordx4 v[172:175], v224, s[18:19] offset:2304 sc1
    global_load_dwordx4 v[144:147], v225, s[18:19] offset:80 sc1
    global_load_dwordx4 v[176:179], v224, s[18:19] offset:2560 sc1
    global_load_dwordx4 v[180:183], v224, s[18:19] offset:2816 sc1
    global_load_dwordx4 v[148:151], v225, s[18:19] offset:96 sc1
    global_load_dwordx4 v[184:187], v224, s[18:19] offset:3072 sc1
    global_load_dwordx4 v[188:191], v224, s[18:19] offset:3328 sc1
L_chkB:
    s_waitcnt vmcnt(0)
    v_xor_b32 v141, s75, v141
    v_xor_b32 v142, v140, v142
    v_xor_b32 v168, s74, v168
    v_xor_b32 v169, s75, v169
    v_xor_b32 v170, s76, v170
    v_xor_b32 v171, s77, v171
    v_xor_b32 v172, s74, v172
    v_xor_b32 v173, s75, v173
    v_xor_b32 v174, s76, v174
    v_xor_b32 v175, s77, v175
    v_xor_b32 v145, s75, v145
    v_xor_b32 v146, v144, v146
    v_xor_b32 v176, s74, v176
    v_xor_b32 v177, s75, v177
    v_xor_b32 v178, s76, v178
    v_xor_b32 v179, s77, v179
    v_xor_b32 v180, s74, v180
    v_xor_b32 v181, s75, v181
    v_xor_b32 v182, s76, v182
    v_xor_b32 v183, s77, v183
    v_xor_b32 v149, s75, v149
    v_xor_b32 v150, v148, v150
    v_xor_b32 v184, s74, v184
    v_xor_b32 v185, s75, v185
    v_xor_b32 v186, s76, v186
    v_xor_b32 v187, s77, v187
    v_xor_b32 v188, s74, v188
    v_xor_b32 v189, s75, v189
    v_xor_b32 v190, s76, v190
    v_xor_b32 v191, s77, v191
    v_msad_u8 v117, v142, s63, 0
    v_msad_u8 v117, v146, s63, v117
    v_msad_u8 v117, v150, s63, v117
    v_or3_b32 v116, v141, v168, v169
    v_or3_b32 v116, v116, v170, v171
    v_or3_b32 v116, v116, v172, v173
    v_or3_b32 v116, v116, v174, v175
    v_or3_b32 v116, v116, v145, v176
    v_or3_b32 v116, v116, v177, v178
    v_or3_b32 v116, v116, v179, v180
    v_or3_b32 v116, v116, v181, v182
    v_or3_b32 v116, v116, v183, v149
    v_or3_b32 v116, v116, v184, v185
    v_or3_b32 v116, v116, v186, v187
    v_or3_b32 v116, v116, v188, v189
    v_or3_b32 v116, v116, v190, v191
    v_and_b32 v116, 0xff, v116
    v_or_b32 v116, v116, v117
    v_cmp_ne_u32 vcc, 0, v116
    s_add_u32 s87, s87, 1
    s_cbranch_vccz L_readyB
    s_sleep 1
    s_cmp_lt_u32 s87, 0x40000
    s_cbranch_scc1 L_reloadB
L_readyB:
    v_max3_f32 v114, v140, v144, v148
    v_sub_f32 v20, v140, v114
    v_sub_f32 v21, v144, v114
    v_sub_f32 v22, v148, v114
    v_mul_f32 v20, s40, v20
    v_mul_f32 v21, s40, v21
    v_mul_f32 v22, s40, v22
    v_exp_f32 v20, v20
    v_exp_f32 v21, v21
    v_exp_f32 v22, v22
    v_mov_b32 v140, v114
    v_mul_f32 v141, v20, v141
    v_pk_mul_f32 v[168:169], v[168:169], v[20:21] op_sel:[0,0] op_sel_hi:[1,0]
    v_pk_mul_f32 v[170:171], v[170:171], v[20:21] op_sel:[0,0] op_sel_hi:[1,0]
    v_pk_mul_f32 v[172:173], v[172:173], v[20:21] op_sel:[0,0] op_sel_hi:[1,0]
    v_pk_mul_f32 v[174:175], v[174:175], v[20:21] op_sel:[0,0] op_sel_hi:[1,0]
    v_fmac_f32 v141, v21, v145
    v_pk_fma_f32 v[168:169], v[176:177], v[20:21], v[168:169] op_sel:[0,1,0] op_sel_hi:[1,1,1]
    v_pk_fma_f32 v[170:171], v[178:179], v[20:21], v[170:171] op_sel:[0,1,0] op_sel_hi:[1,1,1]
    v_pk_fma_f32 v[172:173], v[180:181], v[20:21], v[172:173] op_sel:[0,1,0] op_sel_hi:[1,1,1]
    v_pk_fma_f32 v[174:175], v[182:183], v[20:21], v[174:175] op_sel:[0,1,0] op_sel_hi:[1,1,1]
    v_fmac_f32 v141, v22, v149
    v_pk_fma_f32 v[168:169], v[184:185], v[22:23], v[168:169] op_sel:[0,0,0] op_sel_hi:[1,0,1]
    v_pk_fma_f32 v[170:171], v[186:187], v[22:23], v[170:171] op_sel:[0,0,0] op_sel_hi:[1,0,1]
    v_pk_fma_f32 v[172:173], v[188:189], v[22:23], v[172:173] op_sel:[0,0,0] op_sel_hi:[1,0,1]
    v_pk_fma_f32 v[174:175], v[190:191], v[22:23], v[174:175] op_sel:[0,0,0] op_sel_hi:[1,0,1]
    s_waitcnt lgkmcnt(0)
    s_barrier
    ds_read_b64 v[68:69], v229 offset:8448
    ds_read_b64 v[70:71], v229 offset:24832
    ds_read_b64 v[72:73], v229 offset:41216
    ds_read_b64 v[74:75], v229 offset:57600
    ds_read_b64 v[144:145], v223 offset:30720
    ds_read_b128 v[176:179], v223 offset:28672
    ds_read_b128 v[180:183], v223 offset:29696
    ds_read_b128 v[80:83], v230 offset:0
    ds_read_b128 v[84:87], v230 offset:256
    ds_read_b128 v[88:91], v230 offset:16384
    ds_read_b128 v[92:95], v230 offset:16640
    ds_read_b128 v[96:99], v230 offset:32768
    ds_read_b128 v[100:103], v230 offset:33024
    ds_read_b128 v[104:107], v230 offset:49152
    ds_read_b128 v[108:111], v230 offset:49408
    s_waitcnt lgkmcnt(8)
    v_max3_f32 v114, v68, v70, v72
    v_max3_f32 v114, v114, v74, v140
    v_max_f32 v114, v114, v144
    v_sub_f32 v20, v68, v114
    v_sub_f32 v21, v70, v114
    v_sub_f32 v22, v72, v114
    v_sub_f32 v23, v74, v114
    v_sub_f32 v24, v140, v114
    v_sub_f32 v25, v144, v114
    v_mul_f32 v20, s40, v20
    v_mul_f32 v21, s40, v21
    v_mul_f32 v22, s40, v22
    v_mul_f32 v23, s40, v23
    v_mul_f32 v24, s40, v24
    v_mul_f32 v25, s40, v25
    v_exp_f32 v20, v20
    v_exp_f32 v21, v21
    v_exp_f32 v22, v22
    v_exp_f32 v23, v23
    v_exp_f32 v24, v24
    v_exp_f32 v25, v25
    s_nop 0
    v_mul_f32 v115, v20, v69
    v_fmac_f32 v115, v21, v71
    v_fmac_f32 v115, v22, v73
    v_fmac_f32 v115, v23, v75
    v_fmac_f32 v115, v24, v141
    v_fmac_f32 v115, v25, v145
    v_rcp_f32 v115, v115
    v_pk_mul_f32 v[12:13], v[168:169], v[24:25] op_sel:[0,0] op_sel_hi:[1,0]
    v_pk_mul_f32 v[14:15], v[170:171], v[24:25] op_sel:[0,0] op_sel_hi:[1,0]
    v_pk_mul_f32 v[16:17], v[172:173], v[24:25] op_sel:[0,0] op_sel_hi:[1,0]
    v_pk_mul_f32 v[18:19], v[174:175], v[24:25] op_sel:[0,0] op_sel_hi:[1,0]
    v_pk_fma_f32 v[12:13], v[176:177], v[24:25], v[12:13] op_sel:[0,1,0] op_sel_hi:[1,1,1]
    v_pk_fma_f32 v[14:15], v[178:179], v[24:25], v[14:15] op_sel:[0,1,0] op_sel_hi:[1,1,1]
    v_pk_fma_f32 v[16:17], v[180:181], v[24:25], v[16:17] op_sel:[0,1,0] op_sel_hi:[1,1,1]
    v_pk_fma_f32 v[18:19], v[182:183], v[24:25], v[18:19] op_sel:[0,1,0] op_sel_hi:[1,1,1]
    s_waitcnt lgkmcnt(6)
    v_pk_fma_f32 v[12:13], v[80:81], v[20:21], v[12:13] op_sel:[0,0,0] op_sel_hi:[1,0,1]
    v_pk_fma_f32 v[14:15], v[82:83], v[20:21], v[14:15] op_sel:[0,0,0] op_sel_hi:[1,0,1]
    v_pk_fma_f32 v[16:17], v[84:85], v[20:21], v[16:17] op_sel:[0,0,0] op_sel_hi:[1,0,1]
    v_pk_fma_f32 v[18:19], v[86:87], v[20:21], v[18:19] op_sel:[0,0,0] op_sel_hi:[1,0,1]
    s_waitcnt lgkmcnt(4)
    v_pk_fma_f32 v[12:13], v[88:89], v[20:21], v[12:13] op_sel:[0,1,0] op_sel_hi:[1,1,1]
    v_pk_fma_f32 v[14:15], v[90:91], v[20:21], v[14:15] op_sel:[0,1,0] op_sel_hi:[1,1,1]
    v_pk_fma_f32 v[16:17], v[92:93], v[20:21], v[16:17] op_sel:[0,1,0] op_sel_hi:[1,1,1]
    v_pk_fma_f32 v[18:19], v[94:95], v[20:21], v[18:19] op_sel:[0,1,0] op_sel_hi:[1,1,1]
    s_waitcnt lgkmcnt(2)
    v_pk_fma_f32 v[12:13], v[96:97], v[22:23], v[12:13] op_sel:[0,0,0] op_sel_hi:[1,0,1]
    v_pk_fma_f32 v[14:15], v[98:99], v[22:23], v[14:15] op_sel:[0,0,0] op_sel_hi:[1,0,1]
    v_pk_fma_f32 v[16:17], v[100:101], v[22:23], v[16:17] op_sel:[0,0,0] op_sel_hi:[1,0,1]
    v_pk_fma_f32 v[18:19], v[102:103], v[22:23], v[18:19] op_sel:[0,0,0] op_sel_hi:[1,0,1]
    s_waitcnt lgkmcnt(0)
    v_pk_fma_f32 v[12:13], v[104:105], v[22:23], v[12:13] op_sel:[0,1,0] op_sel_hi:[1,1,1]
    v_pk_fma_f32 v[14:15], v[106:107], v[22:23], v[14:15] op_sel:[0,1,0] op_sel_hi:[1,1,1]
    v_pk_fma_f32 v[16:17], v[108:109], v[22:23], v[16:17] op_sel:[0,1,0] op_sel_hi:[1,1,1]
    v_pk_fma_f32 v[18:19], v[110:111], v[22:23], v[18:19] op_sel:[0,1,0] op_sel_hi:[1,1,1]
    v_pk_mul_f32 v[12:13], v[12:13], v[114:115] op_sel:[0,1] op_sel_hi:[1,1]
    v_pk_mul_f32 v[14:15], v[14:15], v[114:115] op_sel:[0,1] op_sel_hi:[1,1]
    v_pk_mul_f32 v[16:17], v[16:17], v[114:115] op_sel:[0,1] op_sel_hi:[1,1]
    v_pk_mul_f32 v[18:19], v[18:19], v[114:115] op_sel:[0,1] op_sel_hi:[1,1]
    v_cvt_pk_bf16_f32 v20, v12, v13
    v_cvt_pk_bf16_f32 v21, v14, v15
    v_cvt_pk_bf16_f32 v22, v16, v17
    v_cvt_pk_bf16_f32 v23, v18, v19
    global_store_dwordx2 v226, v[20:21], s[14:15]
    global_store_dwordx2 v226, v[22:23], s[14:15] offset:128
    s_branch L_done
L_respec:
    s_waitcnt vmcnt(0)
    s_mov_b32 m0, s39
    s_mov_b32 s22, s58
    buffer_load_dwordx4 v4, s[20:23], s46 offen nt lds
    buffer_load_dwordx4 v5, s[20:23], s46 offen offset:1024 nt lds
    buffer_load_dwordx4 v6, s[20:23], s46 offen offset:2048 nt lds
    buffer_load_dwordx4 v7, s[20:23], s46 offen offset:3072 nt lds
    s_add_u32 m0, s39, 4096
    s_mov_b32 s22, s59
    buffer_load_dwordx4 v4, s[20:23], s47 offen nt lds
    buffer_load_dwordx4 v5, s[20:23], s47 offen offset:1024 nt lds
    buffer_load_dwordx4 v6, s[20:23], s47 offen offset:2048 nt lds
    buffer_load_dwordx4 v7, s[20:23], s47 offen offset:3072 nt lds
    s_add_u32 m0, s39, 8192
    s_mov_b32 s26, s58
    buffer_load_dwordx4 v8, s[24:27], s46 offen nt lds
    buffer_load_dwordx4 v9, s[24:27], s46 offen offset:1024 nt lds
    buffer_load_dwordx4 v10, s[24:27], s46 offen offset:2048 nt lds
    buffer_load_dwordx4 v11, s[24:27], s46 offen offset:3072 nt lds
    s_add_u32 m0, s39, 12288
    s_mov_b32 s26, s59
    buffer_load_dwordx4 v8, s[24:27], s47 offen nt lds
    buffer_load_dwordx4 v9, s[24:27], s47 offen offset:1024 nt lds
    buffer_load_dwordx4 v10, s[24:27], s47 offen offset:2048 nt lds
    buffer_load_dwordx4 v11, s[24:27], s47 offen offset:3072 nt lds
    s_branch L_specok
L_early:
    s_cmp_eq_u32 s62, 1
    s_cbranch_scc1 L_earlyB
    global_load_dwordx4 v[140:143], v225, s[18:19] offset:0 sc1
    global_load_dwordx4 v[168:171], v224, s[18:19] offset:0 sc1
    global_load_dwordx4 v[172:175], v224, s[18:19] offset:256 sc1
    global_load_dwordx4 v[144:147], v225, s[18:19] offset:16 sc1
    global_load_dwordx4 v[176:179], v224, s[18:19] offset:512 sc1
    global_load_dwordx4 v[180:183], v224, s[18:19] offset:768 sc1
    global_load_dwordx4 v[148:151], v225, s[18:19] offset:32 sc1
    global_load_dwordx4 v[184:187], v224, s[18:19] offset:1024 sc1
    global_load_dwordx4 v[188:191], v224, s[18:19] offset:1280 sc1
    global_load_dwordx4 v[152:155], v225, s[18:19] offset:48 sc1
    global_load_dwordx4 v[192:195], v224, s[18:19] offset:1536 sc1
    global_load_dwordx4 v[196:199], v224, s[18:19] offset:1792 sc1
    s_branch L_sm
L_earlyB:
    global_load_dwordx4 v[140:143], v225, s[18:19] offset:64 sc1
    global_load_dwordx4 v[168:171], v224, s[18:19] offset:2048 sc1
    global_load_dwordx4 v[172:175], v224, s[18:19] offset:2304 sc1
    global_load_dwordx4 v[144:147], v225, s[18:19] offset:80 sc1
    global_load_dwordx4 v[176:179], v224, s[18:19] offset:2560 sc1
    global_load_dwordx4 v[180:183], v224, s[18:19] offset:2816 sc1
    global_load_dwordx4 v[148:151], v225, s[18:19] offset:96 sc1
    global_load_dwordx4 v[184:187], v224, s[18:19] offset:3072 sc1
    global_load_dwordx4 v[188:191], v224, s[18:19] offset:3328 sc1
    s_branch L_sm
L_helper:
    s_cmp_lt_u32 s31, 4
    s_cbranch_scc1 L_sh_pro
    v_lshlrev_b32 v87, 2, v3
    s_waitcnt lgkmcnt(0)
    global_load_dword v138, v87, s[12:13]
    v_and_b32 v1, 63, v0
    v_and_b32 v118, 3, v0
    v_lshlrev_b32 v90, 4, v2
    v_lshl_add_u32 v90, v118, 8, v90
    v_mov_b32 v86, 127
    s_mov_b32 s44, 0x000f000f
    s_mov_b32 s45, s44
    s_mov_b32 s37, 0
    s_mov_b32 s20, s6
    s_and_b32 s21, s7, 0xffff
    s_mov_b32 s36, 0
    s_sub_u32 s89, s31, 4
    s_mul_i32 s83, s89, 11
    s_lshr_b32 s83, s83, 5
    s_mul_i32 s88, s83, 3
    s_sub_u32 s89, s89, s88
    s_add_u32 s29, s89, 4
    s_and_b32 s82, s33, 2
    s_and_b32 s88, s83, 2
    s_lshl_b32 s88, s88, 1
    s_or_b32 s33, s88, s82
    s_and_b32 s83, s83, 1
    s_lshl_b32 s83, s83, 2
    s_lshr_b32 s30, s2, 1
    s_add_u32 s30, s30, s89
    s_and_b32 s30, s30, 3
    s_add_u32 s30, s30, s83
    s_lshl_b32 s82, s82, 3
    s_lshr_b32 s86, 0x5e5f5a64, s82
    s_bfe_u32 s87, s86, 0x80008
    s_and_b32 s86, s86, 0xff
    s_cmp_lt_u32 s87, s86
    s_cselect_b32 s34, 1, 0
    s_max_u32 s53, s86, s87
    s_min_u32 s87, s86, s87
    v_lshl_add_u32 v85, v1, 2, s32
    v_mul_u32_u24 v85, 3, v85
    v_add_u32 v85, s89, v85
    s_waitcnt vmcnt(0)
    v_mov_b32 v118, 0x1000
    v_cmp_lt_i32 vcc, 0, v138
    v_min_i32 v138, v138, v118
    v_mov_b32 v119, 0
    v_cndmask_b32 v139, v118, v138, vcc
    v_add_u32 v138, 31, v139
    v_lshrrev_b32 v138, 5, v138
    v_lshl_add_u32 v138, v138, 4, v3
    s_nop 1
    v_sub_u32_dpp v81, v138, v138 row_ror:1 row_mask:0xf bank_mask:0xf
    v_lshrrev_b32 v81, 31, v81
    v_add_u32 v119, v119, v81
    v_sub_u32_dpp v82, v138, v138 row_ror:2 row_mask:0xf bank_mask:0xf
    v_lshrrev_b32 v82, 31, v82
    v_add_u32 v119, v119, v82
    v_sub_u32_dpp v83, v138, v138 row_ror:3 row_mask:0xf bank_mask:0xf
    v_lshrrev_b32 v83, 31, v83
    v_add_u32 v119, v119, v83
    v_sub_u32_dpp v80, v138, v138 row_ror:4 row_mask:0xf bank_mask:0xf
    v_lshrrev_b32 v80, 31, v80
    v_add_u32 v119, v119, v80
    v_sub_u32_dpp v81, v138, v138 row_ror:5 row_mask:0xf bank_mask:0xf
    v_lshrrev_b32 v81, 31, v81
    v_add_u32 v119, v119, v81
    v_sub_u32_dpp v82, v138, v138 row_ror:6 row_mask:0xf bank_mask:0xf
    v_lshrrev_b32 v82, 31, v82
    v_add_u32 v119, v119, v82
    v_sub_u32_dpp v83, v138, v138 row_ror:7 row_mask:0xf bank_mask:0xf
    v_lshrrev_b32 v83, 31, v83
    v_add_u32 v119, v119, v83
    v_sub_u32_dpp v80, v138, v138 row_ror:8 row_mask:0xf bank_mask:0xf
    v_lshrrev_b32 v80, 31, v80
    v_add_u32 v119, v119, v80
    v_sub_u32_dpp v81, v138, v138 row_ror:9 row_mask:0xf bank_mask:0xf
    v_lshrrev_b32 v81, 31, v81
    v_add_u32 v119, v119, v81
    v_sub_u32_dpp v82, v138, v138 row_ror:10 row_mask:0xf bank_mask:0xf
    v_lshrrev_b32 v82, 31, v82
    v_add_u32 v119, v119, v82
    v_sub_u32_dpp v83, v138, v138 row_ror:11 row_mask:0xf bank_mask:0xf
    v_lshrrev_b32 v83, 31, v83
    v_add_u32 v119, v119, v83
    v_sub_u32_dpp v80, v138, v138 row_ror:12 row_mask:0xf bank_mask:0xf
    v_lshrrev_b32 v80, 31, v80
    v_add_u32 v119, v119, v80
    v_sub_u32_dpp v81, v138, v138 row_ror:13 row_mask:0xf bank_mask:0xf
    v_lshrrev_b32 v81, 31, v81
    v_add_u32 v119, v119, v81
    v_sub_u32_dpp v82, v138, v138 row_ror:14 row_mask:0xf bank_mask:0xf
    v_lshrrev_b32 v82, 31, v82
    v_add_u32 v119, v119, v82
    v_sub_u32_dpp v83, v138, v138 row_ror:15 row_mask:0xf bank_mask:0xf
    v_lshrrev_b32 v83, 31, v83
    v_add_u32 v119, v119, v83
    s_sub_u32 s83, 15, s30
    v_cmp_eq_u32 s[66:67], s30, v119
    v_cmp_eq_u32 s[68:69], s83, v119
    s_ff1_i32_b32 s82, s66
    s_ff1_i32_b32 s83, s68
    v_readlane_b32 s84, v138, s82
    v_readlane_b32 s85, v138, s83
    v_readlane_b32 s86, v139, s83
    s_lshl_b32 s82, s82, 3
    s_lshl_b32 s83, s83, 19
    s_or_b32 s82, s82, s83
    s_mul_i32 s82, s82, 0x101
    s_mul_i32 s88, s33, 0x01010101
    s_add_u32 s28, s82, s88
    s_add_u32 s28, s28, 0x01000100
    s_lshr_b32 s84, s84, 4
    s_lshr_b32 s85, s85, 4
    s_sub_i32 s82, s85, s53
    s_max_i32 s82, s82, 0
    s_lshl_b32 s74, s82, 1
    s_min_u32 s78, s85, s53
    s_sub_i32 s82, s78, s87
    s_max_i32 s82, s82, 0
    s_add_u32 s75, s74, s82
    s_sub_i32 s82, s84, s53
    s_max_i32 s82, s82, 0
    s_lshl_b32 s82, s82, 1
    s_add_u32 s76, s75, s82
    s_mov_b32 s79, s84
    s_min_u32 s80, s84, s53
    s_sub_i32 s82, s80, s87
    s_max_i32 s82, s82, 0
    s_add_u32 s77, s76, s82
    v_cmp_ge_u32 s[66:67], v85, s74
    v_cmp_ge_u32 s[68:69], v85, s75
    v_cmp_ge_u32 s[70:71], v85, s76
    v_cmp_gt_u32 s[72:73], s77, v85
    v_mov_b32 v116, s85
    v_mov_b32 v118, 0
    v_mov_b32 v80, s74
    v_mov_b32 v91, s78
    v_mov_b32 v81, s75
    v_mov_b32 v92, s79
    v_mov_b32 v82, s76
    v_mov_b32 v93, s80
    v_cndmask_b32 v118, v118, v80, s[66:67]
    v_cndmask_b32 v116, v116, v91, s[66:67]
    v_cndmask_b32 v118, v118, v81, s[68:69]
    v_cndmask_b32 v116, v116, v92, s[68:69]
    v_cndmask_b32 v118, v118, v82, s[70:71]
    v_cndmask_b32 v116, v116, v93, s[70:71]
    s_xor_b64 vcc, s[66:67], s[68:69]
    s_xor_b64 vcc, vcc, s[70:71]
    v_sub_u32 v118, v85, v118
    v_lshrrev_b32 v80, 1, v118
    v_and_b32 v117, 1, v118
    v_mov_b32 v81, s34
    v_cndmask_b32 v80, v80, v118, vcc
    v_cndmask_b32 v117, v117, v81, vcc
    v_sub_u32 v116, v116, v80
    v_add_u32 v116, -1, v116
    v_cndmask_b32 v81, 2, 0, s[68:69]
    v_add_u32 v117, v117, v81
    v_lshlrev_b32 v119, 3, v117
    v_bfe_u32 v119, s28, v119, 8
    v_med3_i32 v116, v116, 0, v86
    v_lshlrev_b32 v63, 5, v116
    v_lshl_add_u32 v63, v117, 18, v63
    v_lshl_add_u32 v63, v119, 29, v63
    v_lshrrev_b32 v119, 3, v119
    v_lshlrev_b32 v119, 10, v119
    v_lshl_add_u32 v119, v116, 3, v119
    s_nop 0
    v_readfirstlane_b32 s82, v119
    v_readfirstlane_b32 s84, v63
    s_lshr_b32 s83, s82, 10
    s_lshl_b32 s83, s83, 22
    s_and_b32 s82, s82, 0x3ff
    s_lshl_b32 s82, s82, 13
    s_add_u32 s82, s82, s83
    s_lshr_b32 s84, s84, 29
    s_lshl_b32 s84, s84, 8
    s_or_b32 s46, s82, s84
    s_add_u32 s47, s46, 0x8000
    v_readfirstlane_b32 s84, v63
    s_and_b32 s84, s84, 0xffff
    s_sub_i32 s86, s86, s84
    s_max_i32 s86, s86, 0
    s_min_u32 s82, s86, 16
    s_min_u32 s83, s86, 32
    s_sub_u32 s83, s83, s82
    s_lshl_b32 s82, s82, 11
    s_lshl_b32 s83, s83, 11
    s_add_u32 s82, s82, s46
    s_add_u32 s83, s83, s47
    s_min_u32 s58, s82, 71303168
    s_min_u32 s59, s83, 71303168
    s_mov_b32 m0, s39
    s_mov_b32 s22, s58
    buffer_load_dwordx4 v4, s[20:23], s46 offen nt lds
    buffer_load_dwordx4 v5, s[20:23], s46 offen offset:1024 nt lds
    buffer_load_dwordx4 v6, s[20:23], s46 offen offset:2048 nt lds
    buffer_load_dwordx4 v7, s[20:23], s46 offen offset:3072 nt lds
    s_add_u32 m0, s39, 4096
    s_mov_b32 s22, s59
    buffer_load_dwordx4 v4, s[20:23], s47 offen nt lds
    buffer_load_dwordx4 v5, s[20:23], s47 offen offset:1024 nt lds
    buffer_load_dwordx4 v6, s[20:23], s47 offen offset:2048 nt lds
    buffer_load_dwordx4 v7, s[20:23], s47 offen offset:3072 nt lds
    s_bcnt1_i32_b64 s38, s[72:73]
    s_cselect_b64 s[54:55], s[44:45], 0
    s_max_u32 s38, s38, 1
    s_branch L_go
L_sh_pro:
    s_lshl_b32 s34, s31, 4
    s_and_b32 s83, s32, 1
    s_lshl1_add_u32 s83, s34, s83
    v_lshl_add_u32 v134, v2, 3, s83
    s_lshl_b32 s49, s33, 8
    s_mov_b32 s42, 0
    s_mov_b32 s35, 16
    s_lshl_b32 s52, s32, 12
    s_cmp_lt_u32 s32, 2
    s_waitcnt lgkmcnt(0)
    s_cbranch_scc1 L_sh_k
    v_lshlrev_b32 v96, 1, v2
    v_xor_b32 v96, v3, v96
    v_lshl_add_u32 v4, v96, 4, v97
    v_xor_b32 v5, 128, v4
    v_add_u32 v7, 21504, v5
    v_add_u32 v5, 7168, v5
    v_add_u32 v6, 14336, v4
    s_mov_b64 s[6:7], s[8:9]
L_sh_k:
    s_mov_b32 s20, s6
    s_and_b32 s21, s7, 0xffff
    s_and_b32 s83, s42, 63
    v_readlane_b32 s82, v134, s83
    s_mov_b32 m0, s52
    s_add_u32 s52, s52, 0x4000
    s_and_b32 s52, s52, 0xffff
    s_lshl_b32 s82, s82, 15
    s_or_b32 s46, s82, s49
    buffer_load_dwordx4 v4, s[20:23], s46 offen nt lds
    buffer_load_dwordx4 v5, s[20:23], s46 offen offset:1024 nt lds
    buffer_load_dwordx4 v6, s[20:23], s46 offen offset:2048 nt lds
    buffer_load_dwordx4 v7, s[20:23], s46 offen offset:3072 nt lds
    s_add_u32 s42, s42, s35
    s_and_b32 s83, s42, 63
    s_cbranch_scc1 L_7
    v_mov_b32 v134, v135
    v_mov_b32 v135, v136
    v_mov_b32 v136, v137
L_7:
    v_and_b32 v1, 63, v0
    v_and_b32 v118, 3, v0
    v_lshlrev_b32 v90, 4, v2
    v_lshl_add_u32 v90, v118, 8, v90
    v_mov_b32 v86, 127
    s_mov_b32 s44, 0x000f000f
    s_mov_b32 s45, s44
    s_mov_b32 s37, 0
    s_mov_b32 s36, 2
    s_mov_b32 s29, s31
    s_lshl_b32 s83, s32, 5
    s_or_b32 s83, s83, s33
    s_mul_i32 s28, s83, 0x01010101
    s_add_u32 s28, s28, 0x18100800
    s_lshl_b32 s84, s34, 3
    v_lshl_add_u32 v83, v3, 10, s84
    v_lshl_add_u32 v83, v2, 5, v83
    v_mov_b32 v139, 2228224
    s_or_b32 s89, s2, s32
    s_cbranch_scc1 L_sh_noprev
    global_load_dword v133, v139, s[18:19] sc1
L_sh_noprev:
    global_load_dwordx4 v[140:143], v83, s[10:11]
    global_load_dwordx4 v[144:147], v83, s[10:11] offset:16
    v_lshlrev_b32 v89, 1, v3
    v_and_b32 v89, 24, v89
    v_bfe_u32 v89, s28, v89, 8
    v_lshl_add_u32 v88, v89, 10, v90
    v_lshrrev_b32 v89, 1, v89
    v_and_b32 v89, 60, v89
    global_load_dword v62, v89, s[12:13]
    global_load_dwordx4 v[12:15], v88, s[4:5] offset:0
    global_load_dwordx4 v[16:19], v88, s[4:5] offset:64
    global_load_dwordx4 v[20:23], v88, s[4:5] offset:128
    global_load_dwordx4 v[24:27], v88, s[4:5] offset:192
    s_and_b32 s83, s42, 63
    v_readlane_b32 s82, v134, s83
    s_mov_b32 m0, s52
    s_add_u32 s52, s52, 0x4000
    s_and_b32 s52, s52, 0xffff
    s_lshl_b32 s82, s82, 15
    s_or_b32 s46, s82, s49
    buffer_load_dwordx4 v4, s[20:23], s46 offen nt lds
    buffer_load_dwordx4 v5, s[20:23], s46 offen offset:1024 nt lds
    buffer_load_dwordx4 v6, s[20:23], s46 offen offset:2048 nt lds
    buffer_load_dwordx4 v7, s[20:23], s46 offen offset:3072 nt lds
    s_add_u32 s42, s42, s35
    s_and_b32 s83, s42, 63
    s_cbranch_scc1 L_8
    v_mov_b32 v134, v135
    v_mov_b32 v135, v136
    v_mov_b32 v136, v137
L_8:
    s_and_b32 s83, s42, 63
    v_readlane_b32 s82, v134, s83
    s_mov_b32 m0, s52
    s_add_u32 s52, s52, 0x4000
    s_and_b32 s52, s52, 0xffff
    s_lshl_b32 s82, s82, 15
    s_or_b32 s46, s82, s49
    buffer_load_dwordx4 v4, s[20:23], s46 offen nt lds
    buffer_load_dwordx4 v5, s[20:23], s46 offen offset:1024 nt lds
    buffer_load_dwordx4 v6, s[20:23], s46 offen offset:2048 nt lds
    buffer_load_dwordx4 v7, s[20:23], s46 offen offset:3072 nt lds
    s_add_u32 s42, s42, s35
    s_and_b32 s83, s42, 63
    s_cbranch_scc1 L_9
    v_mov_b32 v134, v135
    v_mov_b32 v135, v136
    v_mov_b32 v136, v137
L_9:
    s_mov_b32 s43, 0
    s_branch L_init
L_sh_verify:
    s_or_b32 s89, s2, s32
    s_cbranch_scc1 L_sh_nononce
    v_readfirstlane_b32 s82, v133
    s_mov_b32 s84, 0
    s_bfe_u32 s83, s82, 0x80000
    s_cmp_eq_u32 s83, 0xff
    s_cselect_b32 s83, 0, s83
    s_add_u32 s83, s83, 1
    s_or_b32 s84, s84, s83
    s_bfe_u32 s83, s82, 0x80008
    s_cmp_eq_u32 s83, 0xff
    s_cselect_b32 s83, 0, s83
    s_add_u32 s83, s83, 1
    s_lshl_b32 s83, s83, 8
    s_or_b32 s84, s84, s83
    s_bfe_u32 s83, s82, 0x80010
    s_cmp_eq_u32 s83, 0xff
    s_cselect_b32 s83, 0, s83
    s_add_u32 s83, s83, 1
    s_lshl_b32 s83, s83, 16
    s_or_b32 s84, s84, s83
    s_bfe_u32 s83, s82, 0x80018
    s_cmp_eq_u32 s83, 0xff
    s_cselect_b32 s83, 0, s83
    s_add_u32 s83, s83, 1
    s_lshl_b32 s83, s83, 24
    s_or_b32 s84, s84, s83
    v_mov_b32 v133, s84
    v_mov_b32 v116, 64
    s_mov_b64 exec, 1
    global_store_dword v139, v133, s[18:19] sc1
    s_waitcnt vmcnt(0)
    global_store_dword v116, v133, s[16:17] sc1
    s_mov_b64 exec, -1
L_sh_nononce:
    v_mov_b32 v138, v134
    s_bitcmp1_b32 s32, 0
    s_cselect_b64 vcc, -1, 0
    v_cndmask_b32 v134, v140, v141, vcc
    v_cndmask_b32 v135, v142, v143, vcc
    v_cndmask_b32 v136, v144, v145, vcc
    v_cndmask_b32 v137, v146, v147, vcc
    v_xor_b32_dpp v148, v140, v140 row_newbcast:0 row_mask:0xf bank_mask:0xf
    v_xor_b32_dpp v149, v141, v141 row_newbcast:0 row_mask:0xf bank_mask:0xf
    v_xor_b32_dpp v150, v142, v142 row_newbcast:0 row_mask:0xf bank_mask:0xf
    v_xor_b32_dpp v151, v143, v143 row_newbcast:0 row_mask:0xf bank_mask:0xf
    v_xor_b32_dpp v152, v144, v144 row_newbcast:0 row_mask:0xf bank_mask:0xf
    v_xor_b32_dpp v153, v145, v145 row_newbcast:0 row_mask:0xf bank_mask:0xf
    v_xor_b32_dpp v154, v146, v146 row_newbcast:0 row_mask:0xf bank_mask:0xf
    v_xor_b32_dpp v155, v147, v147 row_newbcast:0 row_mask:0xf bank_mask:0xf
    v_or3_b32 v148, v148, v149, v150
    v_or3_b32 v151, v151, v152, v153
    v_or3_b32 v148, v148, v154, v155
    v_or_b32 v148, v148, v151
    v_cmp_ne_u32 vcc, 0, v148
    s_cmp_eq_u64 vcc, 0
    s_cselect_b32 s35, 16, 1
    v_cmp_ne_u32 s[66:67], v138, v134
    s_or_b64 vcc, vcc, s[66:67]
    s_cbranch_scc0 L_sh_w
    s_waitcnt vmcnt(0)
    s_mov_b32 s42, 0
    s_lshl_b32 s52, s32, 12
    s_mov_b32 s89, 3
L_sh_redo:
    s_and_b32 s83, s42, 63
    v_readlane_b32 s82, v134, s83
    s_mov_b32 m0, s52
    s_add_u32 s52, s52, 0x4000
    s_and_b32 s52, s52, 0xffff
    s_lshl_b32 s82, s82, 15
    s_or_b32 s46, s82, s49
    buffer_load_dwordx4 v4, s[20:23], s46 offen nt lds
    buffer_load_dwordx4 v5, s[20:23], s46 offen offset:1024 nt lds
    buffer_load_dwordx4 v6, s[20:23], s46 offen offset:2048 nt lds
    buffer_load_dwordx4 v7, s[20:23], s46 offen offset:3072 nt lds
    s_add_u32 s42, s42, s35
    s_and_b32 s83, s42, 63
    s_cbranch_scc1 L_10
    v_mov_b32 v134, v135
    v_mov_b32 v135, v136
    v_mov_b32 v136, v137
L_10:
    s_sub_u32 s89, s89, 1
    s_cmp_lg_u32 s89, 0
    s_cbranch_scc1 L_sh_redo
L_sh_loop:
    s_lshl_b32 s82, s35, 1
    s_add_u32 s82, s82, s43
    s_cmp_lt_u32 s82, 256
    s_waitcnt vmcnt(8)
    s_cbranch_scc1 L_sh_w
    s_cmp_eq_u32 s82, 256
    s_waitcnt vmcnt(4)
    s_cbranch_scc1 L_sh_w
    s_waitcnt vmcnt(0)
L_sh_w:
    s_barrier
    s_cmp_lt_u32 s42, 256
    s_cbranch_scc0 L_sh_noiss
    s_and_b32 s83, s42, 63
    v_readlane_b32 s82, v134, s83
    s_mov_b32 m0, s52
    s_add_u32 s52, s52, 0x4000
    s_and_b32 s52, s52, 0xffff
    s_lshl_b32 s82, s82, 15
    s_or_b32 s46, s82, s49
    buffer_load_dwordx4 v4, s[20:23], s46 offen nt lds
    buffer_load_dwordx4 v5, s[20:23], s46 offen offset:1024 nt lds
    buffer_load_dwordx4 v6, s[20:23], s46 offen offset:2048 nt lds
    buffer_load_dwordx4 v7, s[20:23], s46 offen offset:3072 nt lds
    s_add_u32 s42, s42, s35
    s_and_b32 s83, s42, 63
    s_cbranch_scc1 L_11
    v_mov_b32 v134, v135
    v_mov_b32 v135, v136
    v_mov_b32 v136, v137
L_11:
L_sh_noiss:
    s_cmp_eq_u32 s37, 8
    s_cbranch_scc0 L_sh_nosig
    s_load_dword s63, s[16:17], 0x40
L_sh_nosig:
    s_bfe_u32 s82, s43, 0x20004
    s_lshl_b32 s82, s82, 2
    s_lshr_b32 s83, s43, 6
    s_add_u32 s82, s82, s83
    s_add_u32 s82, s82, s34
    s_lshl_b32 s48, s82, 5
    s_mov_b64 s[50:51], -1
    s_cmp_eq_u32 s35, 16
    s_cbranch_scc1 L_sh_go
    s_and_b32 s82, s43, 3
    s_lshl_b32 s82, s82, 2
    s_lshl_b64 s[50:51], s[44:45], s82
    s_bfe_u32 s82, s43, 0x20002
    s_cmp_eq_u32 s82, s32
    s_cbranch_scc0 L_sh_next
L_sh_go:
    ds_read_b128 v[80:83], v120
    ds_read_b128 v[84:87], v120 offset:4096
    ds_read_b128 v[88:91], v121
    ds_read_b128 v[92:95], v121 offset:4096
    ds_read_b128 v[96:99], v122
    ds_read_b128 v[100:103], v122 offset:4096
    ds_read_b128 v[104:107], v123
    ds_read_b128 v[108:111], v123 offset:4096
    v_subrev_u32 v112, s48, v62
    v_cndmask_b32 v112, 0, v112, s[50:51]
    v_cndmask_b32 v113, v67, v66, s[50:51]
    v_cmp_gt_i32 s[56:57], 20, v112
    s_waitcnt lgkmcnt(6)
    v_mfma_f32_16x16x32_bf16 v[68:71], v[80:83], v[12:15], 0
    v_mfma_f32_16x16x32_bf16 v[72:75], v[84:87], v[12:15], 0
    s_waitcnt lgkmcnt(4)
    v_mfma_f32_16x16x32_bf16 v[68:71], v[88:91], v[16:19], v[68:71]
    v_mfma_f32_16x16x32_bf16 v[72:75], v[92:95], v[16:19], v[72:75]
    s_waitcnt lgkmcnt(2)
    v_mfma_f32_16x16x32_bf16 v[68:71], v[96:99], v[20:23], v[68:71]
    v_mfma_f32_16x16x32_bf16 v[72:75], v[100:103], v[20:23], v[72:75]
    s_waitcnt lgkmcnt(0)
    v_mfma_f32_16x16x32_bf16 v[68:71], v[104:107], v[24:27], v[68:71]
    v_mfma_f32_16x16x32_bf16 v[72:75], v[108:111], v[24:27], v[72:75]
    s_nop 3
    ds_read_b64_tr_b16 v[80:81], v124 offset:8192
    ds_read_b64_tr_b16 v[82:83], v124 offset:12288
    ds_read_b64_tr_b16 v[84:85], v125 offset:8192
    ds_read_b64_tr_b16 v[86:87], v125 offset:12288
    ds_read_b64_tr_b16 v[88:89], v126 offset:8192
    ds_read_b64_tr_b16 v[90:91], v126 offset:12288
    ds_read_b64_tr_b16 v[92:93], v127 offset:8192
    ds_read_b64_tr_b16 v[94:95], v127 offset:12288
    ds_read_b64_tr_b16 v[96:97], v128 offset:8192
    ds_read_b64_tr_b16 v[98:99], v128 offset:12288
    ds_read_b64_tr_b16 v[100:101], v129 offset:8192
    ds_read_b64_tr_b16 v[102:103], v129 offset:12288
    ds_read_b64_tr_b16 v[104:105], v130 offset:8192
    ds_read_b64_tr_b16 v[106:107], v130 offset:12288
    ds_read_b64_tr_b16 v[108:109], v131 offset:8192
    ds_read_b64_tr_b16 v[110:111], v131 offset:12288
    s_cmp_eq_u64 s[56:57], 0
    s_cbranch_scc1 L_12
    v_cmp_lt_i32 s[66:67], 0, v112
    v_cmp_lt_i32 s[68:69], 1, v112
    v_cmp_lt_i32 s[70:71], 2, v112
    v_cmp_lt_i32 s[72:73], 3, v112
    v_cmp_lt_i32 s[74:75], 16, v112
    v_cmp_lt_i32 s[76:77], 17, v112
    v_cmp_lt_i32 s[78:79], 18, v112
    v_cmp_lt_i32 s[80:81], 19, v112
    v_cndmask_b32 v68, v113, v68, s[66:67]
    v_cndmask_b32 v69, v113, v69, s[68:69]
    v_cndmask_b32 v70, v113, v70, s[70:71]
    v_cndmask_b32 v71, v113, v71, s[72:73]
    v_cndmask_b32 v72, v113, v72, s[74:75]
    v_cndmask_b32 v73, v113, v73, s[76:77]
    v_cndmask_b32 v74, v113, v74, s[78:79]
    v_cndmask_b32 v75, v113, v75, s[80:81]
L_12:
    v_max3_f32 v114, v68, v69, v70
    v_max3_f32 v116, v71, v72, v73
    v_max3_f32 v114, v114, v74, v75
    v_max3_f32 v114, v114, v116, v60
    v_mov_b32 v116, v114
    s_nop 1
    v_permlane32_swap_b32 v114, v116
    v_max_f32 v114, v114, v116
    v_mov_b32 v116, v114
    s_nop 1
    v_permlane16_swap_b32 v114, v116
    v_max_f32 v114, v114, v116
    v_mul_f32 v117, s40, v114
    v_sub_f32 v115, v60, v114
    v_cmp_lt_f32 vcc, v60, v114
    v_fma_f32 v68, v68, s40, -v117
    v_fma_f32 v69, v69, s40, -v117
    v_fma_f32 v70, v70, s40, -v117
    v_fma_f32 v71, v71, s40, -v117
    v_fma_f32 v72, v72, s40, -v117
    v_fma_f32 v73, v73, s40, -v117
    v_fma_f32 v74, v74, s40, -v117
    v_fma_f32 v75, v75, s40, -v117
    v_mul_f32 v115, s40, v115
    v_exp_f32 v68, v68
    v_exp_f32 v69, v69
    v_exp_f32 v70, v70
    v_exp_f32 v71, v71
    v_exp_f32 v72, v72
    v_exp_f32 v73, v73
    v_exp_f32 v74, v74
    v_exp_f32 v75, v75
    v_exp_f32 v115, v115
    v_mov_b32 v60, v114
    v_cvt_pk_bf16_f32 v76, v68, v69
    v_cvt_pk_bf16_f32 v77, v70, v71
    v_cvt_pk_bf16_f32 v78, v72, v73
    v_cvt_pk_bf16_f32 v79, v74, v75
    v_pk_add_f32 v[68:69], v[68:69], v[70:71]
    v_pk_add_f32 v[72:73], v[72:73], v[74:75]
    v_pk_add_f32 v[68:69], v[68:69], v[72:73]
    v_fma_f32 v61, v61, v115, v68
    v_add_f32 v61, v61, v69
    s_cbranch_vccz L_13
    v_pk_mul_f32 v[28:29], v[28:29], v[114:115] op_sel:[0,1] op_sel_hi:[1,1]
    v_pk_mul_f32 v[30:31], v[30:31], v[114:115] op_sel:[0,1] op_sel_hi:[1,1]
    v_pk_mul_f32 v[32:33], v[32:33], v[114:115] op_sel:[0,1] op_sel_hi:[1,1]
    v_pk_mul_f32 v[34:35], v[34:35], v[114:115] op_sel:[0,1] op_sel_hi:[1,1]
    v_pk_mul_f32 v[36:37], v[36:37], v[114:115] op_sel:[0,1] op_sel_hi:[1,1]
    v_pk_mul_f32 v[38:39], v[38:39], v[114:115] op_sel:[0,1] op_sel_hi:[1,1]
    v_pk_mul_f32 v[40:41], v[40:41], v[114:115] op_sel:[0,1] op_sel_hi:[1,1]
    v_pk_mul_f32 v[42:43], v[42:43], v[114:115] op_sel:[0,1] op_sel_hi:[1,1]
    v_pk_mul_f32 v[44:45], v[44:45], v[114:115] op_sel:[0,1] op_sel_hi:[1,1]
    v_pk_mul_f32 v[46:47], v[46:47], v[114:115] op_sel:[0,1] op_sel_hi:[1,1]
    v_pk_mul_f32 v[48:49], v[48:49], v[114:115] op_sel:[0,1] op_sel_hi:[1,1]
    v_pk_mul_f32 v[50:51], v[50:51], v[114:115] op_sel:[0,1] op_sel_hi:[1,1]
    v_pk_mul_f32 v[52:53], v[52:53], v[114:115] op_sel:[0,1] op_sel_hi:[1,1]
    v_pk_mul_f32 v[54:55], v[54:55], v[114:115] op_sel:[0,1] op_sel_hi:[1,1]
    v_pk_mul_f32 v[56:57], v[56:57], v[114:115] op_sel:[0,1] op_sel_hi:[1,1]
    v_pk_mul_f32 v[58:59], v[58:59], v[114:115] op_sel:[0,1] op_sel_hi:[1,1]
L_13:
    s_waitcnt lgkmcnt(0)
    v_mfma_f32_16x16x32_bf16 v[28:31], v[80:83], v[76:79], v[28:31]
    v_mfma_f32_16x16x32_bf16 v[32:35], v[84:87], v[76:79], v[32:35]
    v_mfma_f32_16x16x32_bf16 v[36:39], v[88:91], v[76:79], v[36:39]
    v_mfma_f32_16x16x32_bf16 v[40:43], v[92:95], v[76:79], v[40:43]
    v_mfma_f32_16x16x32_bf16 v[44:47], v[96:99], v[76:79], v[44:47]
    v_mfma_f32_16x16x32_bf16 v[48:51], v[100:103], v[76:79], v[48:51]
    v_mfma_f32_16x16x32_bf16 v[52:55], v[104:107], v[76:79], v[52:55]
    v_mfma_f32_16x16x32_bf16 v[56:59], v[108:111], v[76:79], v[56:59]
L_sh_next:
    s_add_u32 s37, s37, 1
    s_bitcmp1_b32 s37, 0
    s_cselect_b32 s82, 1, 3
    s_lshl_b32 s82, s82, 14
    v_xor_b32 v120, s82, v120
    v_xor_b32 v121, s82, v121
    v_xor_b32 v122, s82, v122
    v_xor_b32 v123, s82, v123
    v_xor_b32 v124, s82, v124
    v_xor_b32 v125, s82, v125
    v_xor_b32 v126, s82, v126
    v_xor_b32 v127, s82, v127
    v_xor_b32 v128, s82, v128
    v_xor_b32 v129, s82, v129
    v_xor_b32 v130, s82, v130
    v_xor_b32 v131, s82, v131
    s_add_u32 s43, s43, s35
    s_cmp_lt_u32 s43, 256
    s_cbranch_scc1 L_sh_loop
    v_mov_b32 v116, v61
    s_nop 1
    v_permlane32_swap_b32 v61, v116
    v_add_f32 v61, v61, v116
    v_mov_b32 v116, v61
    s_nop 1
    v_permlane16_swap_b32 v61, v116
    v_add_f32 v61, v61, v116
    v_lshlrev_b32 v229, 1, v3
    v_and_b32 v229, 24, v229
    v_bfe_u32 v229, s28, v229, 8
    v_and_b32 v225, 3, v3
    v_lshl_add_u32 v229, v229, 2, v225
    s_lshl_b32 s85, s29, 4
    s_add_u32 s85, s85, 2097152
    v_lshl_add_u32 v225, v229, 7, s85
    s_waitcnt lgkmcnt(0)
    s_mov_b32 s87, 0
    v_mov_b32 v116, 64
L_14:
    s_cmp_lg_u32 s63, 0
    s_cbranch_scc1 L_15
    global_load_dword v133, v116, s[16:17] sc1
    s_sleep 8
    s_add_u32 s87, s87, 1
    s_waitcnt vmcnt(0)
    v_readfirstlane_b32 s63, v133
    s_cmp_lt_u32 s87, 0x40000
    s_cbranch_scc1 L_14
L_15:
    v_mov_b32 v133, s63
    s_mov_b32 s74, 0x07060500
    s_mov_b32 s75, 0x07060501
    s_mov_b32 s76, 0x07060502
    s_mov_b32 s77, 0x07060503
    v_perm_b32 v28, v28, v133, s74
    v_perm_b32 v29, v29, v133, s75
    v_perm_b32 v30, v30, v133, s76
    v_perm_b32 v31, v31, v133, s77
    v_perm_b32 v32, v32, v133, s74
    v_perm_b32 v33, v33, v133, s75
    v_perm_b32 v34, v34, v133, s76
    v_perm_b32 v35, v35, v133, s77
    v_perm_b32 v36, v36, v133, s74
    v_perm_b32 v37, v37, v133, s75
    v_perm_b32 v38, v38, v133, s76
    v_perm_b32 v39, v39, v133, s77
    v_perm_b32 v40, v40, v133, s74
    v_perm_b32 v41, v41, v133, s75
    v_perm_b32 v42, v42, v133, s76
    v_perm_b32 v43, v43, v133, s77
    v_perm_b32 v44, v44, v133, s74
    v_perm_b32 v45, v45, v133, s75
    v_perm_b32 v46, v46, v133, s76
    v_perm_b32 v47, v47, v133, s77
    v_perm_b32 v48, v48, v133, s74
    v_perm_b32 v49, v49, v133, s75
    v_perm_b32 v50, v50, v133, s76
    v_perm_b32 v51, v51, v133, s77
    v_perm_b32 v52, v52, v133, s74
    v_perm_b32 v53, v53, v133, s75
    v_perm_b32 v54, v54, v133, s76
    v_perm_b32 v55, v55, v133, s77
    v_perm_b32 v56, v56, v133, s74
    v_perm_b32 v57, v57, v133, s75
    v_perm_b32 v58, v58, v133, s76
    v_perm_b32 v59, v59, v133, s77
    v_perm_b32 v61, v61, v133, s75
    v_xor_b32 v62, v60, v133
    v_mov_b32 v63, v133
    s_barrier
    ds_write_b128 v227, v[28:31] offset:0
    ds_write_b128 v227, v[32:35] offset:64
    ds_write_b128 v227, v[36:39] offset:128
    ds_write_b128 v227, v[40:43] offset:192
    ds_write_b128 v227, v[44:47] offset:256
    ds_write_b128 v227, v[48:51] offset:320
    ds_write_b128 v227, v[52:55] offset:384
    ds_write_b128 v227, v[56:59] offset:448
    v_mul_u32_u24 v230, 528, v2
    v_lshl_add_u32 v230, v3, 4, v230
    v_add_u32 v230, s39, v230
    v_lshlrev_b32 v231, 12, v2
    v_lshl_add_u32 v231, v3, 4, v231
    s_lshl_b32 s88, s29, 9
    s_waitcnt lgkmcnt(0)
    ds_read_b128 v[80:83], v230 offset:0
    ds_read_b128 v[84:87], v230 offset:256
    ds_read_b128 v[88:91], v230 offset:2112
    ds_read_b128 v[92:95], v230 offset:2368
    ds_read_b128 v[96:99], v230 offset:4224
    ds_read_b128 v[100:103], v230 offset:4480
    ds_read_b128 v[104:107], v230 offset:6336
    ds_read_b128 v[108:111], v230 offset:6592
    s_mov_b64 exec, 0xffff
    global_store_dwordx4 v225, v[60:63], s[18:19] sc1
    s_mov_b64 exec, -1
    s_bfe_u32 s85, s28, 0x80000
    s_lshl_b32 s85, s85, 14
    s_add_u32 s85, s85, s88
    v_add_u32 v68, s85, v231
    s_waitcnt lgkmcnt(6)
    global_store_dwordx4 v68, v[80:83], s[18:19] sc1
    global_store_dwordx4 v68, v[84:87], s[18:19] offset:256 sc1
    s_bfe_u32 s85, s28, 0x80008
    s_lshl_b32 s85, s85, 14
    s_add_u32 s85, s85, s88
    v_add_u32 v69, s85, v231
    s_waitcnt lgkmcnt(4)
    global_store_dwordx4 v69, v[88:91], s[18:19] sc1
    global_store_dwordx4 v69, v[92:95], s[18:19] offset:256 sc1
    s_bfe_u32 s85, s28, 0x80010
    s_lshl_b32 s85, s85, 14
    s_add_u32 s85, s85, s88
    v_add_u32 v70, s85, v231
    s_waitcnt lgkmcnt(2)
    global_store_dwordx4 v70, v[96:99], s[18:19] sc1
    global_store_dwordx4 v70, v[100:103], s[18:19] offset:256 sc1
    s_bfe_u32 s85, s28, 0x80018
    s_lshl_b32 s85, s85, 14
    s_add_u32 s85, s85, s88
    v_add_u32 v71, s85, v231
    s_waitcnt lgkmcnt(0)
    global_store_dwordx4 v71, v[104:107], s[18:19] sc1
    global_store_dwordx4 v71, v[108:111], s[18:19] offset:256 sc1
L_done:
L_end:
    s_endpgm
.section .rodata,"a"
.p2align 6
.amdhsa_kernel standalone__paged_block_table_kv_radixattention__sampling_kernel
  .amdhsa_next_free_vgpr 232
  .amdhsa_next_free_sgpr 102
  .amdhsa_accum_offset 232
  .amdhsa_group_segment_fixed_size 0
  .amdhsa_kernarg_size 64
  .amdhsa_user_sgpr_count 2
  .amdhsa_user_sgpr_kernarg_segment_ptr 1
  .amdhsa_system_sgpr_workgroup_id_x 1
.end_amdhsa_kernel
```
